```python
import torch

def _softmax(x, axis=-1):
    return torch.softmax(x, dim=axis)
def _gelu(x):
    return torch.nn.functional.gelu(x, approximate="tanh")
def _silu(x):
    return torch.nn.functional.silu(x)
def _sigmoid(x):
    return torch.sigmoid(x)
def _layernorm(x, axis=-1, eps=1e-5):
    m = x.mean(dim=axis, keepdim=True)
    v = x.var(dim=axis, keepdim=True, unbiased=False)
    return (x - m) / torch.sqrt(v + eps)
def _scatter_add(tgt, idx, src, axis=0):
    return tgt.clone().index_add_(axis, idx, src)
def _segment_sum(src, seg, n):
    out = torch.zeros((n,) + src.shape[1:], dtype=src.dtype)
    return out.index_add_(0, seg, src)
def _pad(x, pw):
    flat = tuple(v for pair in reversed(pw) for v in pair)
    return torch.nn.functional.pad(x, flat)

kernel_name = 'parallel_sum__sliding_block_cached__glu_gated_bilinear__decode'

def setup_inputs():

    _w = (lambda a: (lambda t: t.to(torch.bfloat16) if t.is_floating_point() else t)(torch.as_tensor(a)))
    def _A_setup():
        B, Sq, D = 1, 1, 512
        Hq, Hkv, Sk, Dh = 32, 8, 65536, 128
        assert Hq % Hkv == 0, (Hq, Hkv)
        return {
            "x": _w((lambda *s: torch.randn(*s, dtype=torch.bfloat16) * 0.05)(B, Sq, D)),
            "k_cache": _w((lambda *s: torch.randn(*s, dtype=torch.bfloat16) * 1.6)(B, Hkv, Sk, Dh)),
            "v_cache": _w((lambda *s: torch.randn(*s, dtype=torch.bfloat16) * 0.8)(B, Hkv, Sk, Dh)),
            "wq": _w((lambda *s: torch.randn(*s, dtype=torch.bfloat16) * 1.6)(D, Hq * Dh) * (D ** -0.5)),
            "wo": _w((lambda *s: torch.randn(*s, dtype=torch.bfloat16) * 0.8)(Hq * Dh, D) * ((Hq * Dh) ** -0.5)),
        }
    _A_in = _A_setup()

    def _B_setup():
        B, S, D, F = 1, 1, 512, 1792
        return {
            "x": _w((lambda *s: torch.randn(*s, dtype=torch.bfloat16) * 0.05)(B, S, D)),
            "w_gate": _w((lambda *s: torch.randn(*s, dtype=torch.bfloat16) * 0.4)(D, F) * (D ** -0.5)),
            "w_up": _w((lambda *s: torch.randn(*s, dtype=torch.bfloat16) * 0.4)(D, F) * (D ** -0.5)),
            "w_down": _w((lambda *s: torch.randn(*s, dtype=torch.bfloat16) * 0.4)(F, D) * (F ** -0.5)),
        }
    _B_in = _B_setup()

    return {
        "A_x": _A_in["x"],
        "A_k_cache": _A_in["k_cache"],
        "A_v_cache": _A_in["v_cache"],
        "A_wq": _A_in["wq"],
        "A_wo": _A_in["wo"],
        "B_x": _B_in["x"],
        "B_w_gate": _B_in["w_gate"],
        "B_w_up": _B_in["w_up"],
        "B_w_down": _B_in["w_down"],
    }

def reference(A_x, A_k_cache, A_v_cache, A_wq, A_wo, B_x, B_w_gate, B_w_up, B_w_down):
    def _A_ref(x, k_cache, v_cache, wq, wo):
        B, Sq, D = x.shape
        Hq, Dh = 32, 128
        Hkv, Sk = k_cache.shape[1], k_cache.shape[2]
        W = min(4096, max(256, Sk // 4))
        rep = Hq // Hkv
        q = (lambda x, *d: x.permute(*d))((x @ wq).reshape(B, Sq, Hq, Dh), 0, 2, 1, 3)
        k = (lambda x, n, axis: torch.repeat_interleave(x, n, dim=axis))(k_cache[:, :, Sk - W:, :], rep, axis=1)
        v = (lambda x, n, axis: torch.repeat_interleave(x, n, dim=axis))(v_cache[:, :, Sk - W:, :], rep, axis=1)
        scores = torch.einsum("bhqd,bhkd->bhqk", q, k) * (Dh ** -0.5)
        p = _softmax(scores, axis=-1)
        o = torch.einsum("bhqk,bhkd->bhqd", p, v)
        return (lambda x, *d: x.permute(*d))(o, 0, 2, 1, 3).reshape(B, Sq, Hq * Dh) @ wo

    def _B_ref(x, w_gate, w_up, w_down):
        g = torch.einsum("bsd,df->bsf", x, w_gate)
        u = torch.einsum("bsd,df->bsf", x, w_up)
        h = g * u
        return torch.einsum("bsf,fd->bsd", h, w_down)

    x = A_x
    xn = _layernorm(x, axis=-1)
    return x + _A_ref(xn, A_k_cache, A_v_cache, A_wq, A_wo) + _B_ref(xn, B_w_gate, B_w_up, B_w_down)
```

```asm
; @launch grid=(256,1,1) block=(320,1,1) lds=127808
.amdgcn_target "amdgcn-amd-amdhsa--gfx950"
.text
.globl parallel_sum__sliding_block_cached__glu_gated_bilinear__decode_kernel
.p2align 8
.type parallel_sum__sliding_block_cached__glu_gated_bilinear__decode_kernel,@function
parallel_sum__sliding_block_cached__glu_gated_bilinear__decode_kernel:
    s_cmp_ge_u32 s2, 256
    s_cbranch_scc1 L_end
    s_load_dwordx2 s[4:5], s[0:1], 0
    s_load_dwordx2 s[16:17], s[0:1], 24
    s_load_dwordx2 s[8:9], s[0:1], 8
    s_load_dwordx2 s[12:13], s[0:1], 16
    s_load_dwordx2 s[40:41], s[0:1], 88
    v_lshrrev_b32 v5, 6, v0
    s_and_b32 s44, s2, 7
    v_readfirstlane_b32 s46, v5
    s_lshr_b32 s45, s2, 3
    v_and_b32 v1, 63, v0
    s_cmp_eq_u32 s46, 0
    s_cbranch_scc1 L_loader
    s_sub_u32 s46, s46, 1
    s_getpc_b64 s[92:93]
L_pce:
    s_lshl_b32 s94, s45, 2
    s_add_u32 s94, s94, s46
    s_lshl_b32 s94, s94, 6
    s_add_u32 s94, s94, 192
    s_min_u32 s94, s94, L_end-L_pce
    s_load_dword s95, s[92:93], s94
    s_branch L_compute
L_loader:
    s_setprio 3
    s_mov_b32 s46, 4
    s_mov_b32 s6, 0x400
    s_mov_b32 s7, 0x20000
    s_mov_b32 s18, 0x400000
    s_mov_b32 s19, 0x20000
    v_lshlrev_b32 v11, 4, v1
    v_lshrrev_b32 v6, 3, v1
    v_and_b32 v5, 7, v1
    v_and_b32 v7, 6, v6
    v_xor_b32 v5, v5, v7
    v_lshlrev_b32 v5, 4, v5
    v_lshl_add_u32 v12, v6, 13, v5
    s_lshr_b32 s54, s45, 3
    s_lshl_b32 s55, s54, 20
    s_lshl_b32 s54, s44, 10
    s_add_u32 s55, s55, s54
    s_and_b32 s54, s45, 7
    s_lshl_b32 s54, s54, 7
    s_add_u32 s55, s55, s54
    s_mov_b32 m0, 122880
    s_waitcnt lgkmcnt(0)
    buffer_load_dwordx4 v11, s[4:7], 0 offen lds
    s_mov_b32 m0, 65536
    s_add_u32 s54, s55, 64512
    s_add_u32 s56, s55, 129024
    s_add_u32 s57, s55, 193536
    s_mov_b32 s60, 4
L_wqloop:
    buffer_load_dwordx4 v12, s[16:19], s55 offen nt lds
    buffer_load_dwordx4 v12, s[16:19], s54 offen offset:1024 nt lds
    buffer_load_dwordx4 v12, s[16:19], s56 offen offset:2048 nt lds
    buffer_load_dwordx4 v12, s[16:19], s57 offen offset:3072 nt lds
    s_add_u32 m0, m0, 4096
    s_add_u32 s55, s55, 0x40000
    s_add_u32 s54, s54, 0x40000
    s_add_u32 s56, s56, 0x40000
    s_add_u32 s57, s57, 0x40000
    s_sub_u32 s60, s60, 1
    s_cmp_lg_u32 s60, 0
    s_cbranch_scc1 L_wqloop
    s_load_dwordx2 s[20:21], s[0:1], 32
    s_load_dwordx2 s[24:25], s[0:1], 48
    s_load_dwordx2 s[28:29], s[0:1], 56
    s_load_dwordx2 s[32:33], s[0:1], 64
    s_load_dwordx2 s[36:37], s[0:1], 72
    s_mov_b32 s10, 0x8000000
    s_mov_b32 s11, 0x20000
    s_mov_b32 s14, 0x8000000
    s_mov_b32 s15, 0x20000
    s_mov_b32 s42, 0x400000
    s_mov_b32 s43, 0x20000
    s_mov_b32 s22, 0x400000
    s_mov_b32 s23, 0x20000
    s_mov_b32 s38, 0x400
    s_mov_b32 s39, 0x20000
    v_lshrrev_b32 v2, 4, v1
    v_and_b32 v3, 15, v1
    v_mov_b32 v9, 127680
    v_mov_b32 v10, 1
    s_lshl_b32 s59, s44, 5
    s_add_u32 s59, s59, s45
    s_cmp_gt_u32 s44, 7
    s_cselect_b32 s3, 1, 0
    s_sub_u32 s3, s44, s3
    s_cmp_eq_u32 s44, 7
    s_cselect_b32 s3, 7, s3
    s_lshl_b32 s3, s3, 5
    s_add_u32 s3, s3, s45
    s_lshl_b32 s52, s44, 24
    s_lshl_b32 s56, s45, 12
    s_add_u32 s52, s52, s56
    s_add_u32 s52, s52, 0xF00000
    v_xor_b32 v5, v3, v2
    v_lshlrev_b32 v5, 4, v5
    v_lshl_add_u32 v14, v2, 8, v5
    v_xor_b32 v15, 64, v14
    v_xor_b32 v16, 0x80, v14
    v_xor_b32 v17, 0xc0, v14
    s_mov_b32 m0, 0
    s_add_u32 s56, s52, 0
    buffer_load_dwordx4 v14, s[8:11], s56 offen offset:0 nt lds
    buffer_load_dwordx4 v15, s[8:11], s56 offen offset:1024 nt lds
    buffer_load_dwordx4 v16, s[8:11], s56 offen offset:2048 nt lds
    s_barrier
    s_waitcnt vmcnt(19)
    s_mov_b64 exec, 1
    ds_write_b32 v9, v10 offset:0
    s_mov_b64 exec, -1
    buffer_load_dwordx4 v17, s[8:11], s56 offen offset:3072 nt lds
    s_waitcnt vmcnt(19)
    s_mov_b32 m0, 4096
    s_add_u32 s56, s52, 131072
    buffer_load_dwordx4 v14, s[8:11], s56 offen offset:0 nt lds
    s_waitcnt vmcnt(19)
    buffer_load_dwordx4 v15, s[8:11], s56 offen offset:1024 nt lds
    s_waitcnt vmcnt(19)
    buffer_load_dwordx4 v16, s[8:11], s56 offen offset:2048 nt lds
    s_waitcnt vmcnt(19)
    buffer_load_dwordx4 v17, s[8:11], s56 offen offset:3072 nt lds
    s_waitcnt vmcnt(19)
    s_mov_b32 m0, 8192
    s_add_u32 s56, s52, 262144
    buffer_load_dwordx4 v14, s[8:11], s56 offen offset:0 nt lds
    s_waitcnt vmcnt(19)
    buffer_load_dwordx4 v15, s[8:11], s56 offen offset:1024 nt lds
    s_waitcnt vmcnt(19)
    buffer_load_dwordx4 v16, s[8:11], s56 offen offset:2048 nt lds
    s_waitcnt vmcnt(19)
    buffer_load_dwordx4 v17, s[8:11], s56 offen offset:3072 nt lds
    s_waitcnt vmcnt(19)
    s_mov_b32 m0, 12288
    s_add_u32 s56, s52, 393216
    buffer_load_dwordx4 v14, s[8:11], s56 offen offset:0 nt lds
    s_waitcnt vmcnt(19)
    buffer_load_dwordx4 v15, s[8:11], s56 offen offset:1024 nt lds
    s_waitcnt vmcnt(19)
    buffer_load_dwordx4 v16, s[8:11], s56 offen offset:2048 nt lds
    s_waitcnt vmcnt(19)
    buffer_load_dwordx4 v17, s[8:11], s56 offen offset:3072 nt lds
    s_waitcnt vmcnt(19)
    s_mov_b32 m0, 16384
    s_add_u32 s56, s52, 524288
    buffer_load_dwordx4 v14, s[8:11], s56 offen offset:0 nt lds
    s_waitcnt vmcnt(19)
    buffer_load_dwordx4 v15, s[8:11], s56 offen offset:1024 nt lds
    s_waitcnt vmcnt(19)
    buffer_load_dwordx4 v16, s[8:11], s56 offen offset:2048 nt lds
    s_waitcnt vmcnt(19)
    s_mov_b64 exec, 1
    ds_write_b32 v9, v10 offset:4
    s_mov_b64 exec, -1
    buffer_load_dwordx4 v17, s[8:11], s56 offen offset:3072 nt lds
    s_waitcnt vmcnt(19)
    s_mov_b32 m0, 20480
    s_add_u32 s56, s52, 655360
    buffer_load_dwordx4 v14, s[8:11], s56 offen offset:0 nt lds
    s_waitcnt vmcnt(19)
    buffer_load_dwordx4 v15, s[8:11], s56 offen offset:1024 nt lds
    s_waitcnt vmcnt(19)
    buffer_load_dwordx4 v16, s[8:11], s56 offen offset:2048 nt lds
    s_waitcnt vmcnt(19)
    buffer_load_dwordx4 v17, s[8:11], s56 offen offset:3072 nt lds
    s_waitcnt vmcnt(19)
    s_mov_b32 m0, 24576
    s_add_u32 s56, s52, 786432
    buffer_load_dwordx4 v14, s[8:11], s56 offen offset:0 nt lds
    s_waitcnt vmcnt(19)
    buffer_load_dwordx4 v15, s[8:11], s56 offen offset:1024 nt lds
    s_waitcnt vmcnt(19)
    buffer_load_dwordx4 v16, s[8:11], s56 offen offset:2048 nt lds
    s_waitcnt vmcnt(19)
    buffer_load_dwordx4 v17, s[8:11], s56 offen offset:3072 nt lds
    s_waitcnt vmcnt(19)
    s_mov_b32 m0, 28672
    s_add_u32 s56, s52, 917504
    buffer_load_dwordx4 v14, s[8:11], s56 offen offset:0 nt lds
    s_waitcnt vmcnt(19)
    buffer_load_dwordx4 v15, s[8:11], s56 offen offset:1024 nt lds
    s_waitcnt vmcnt(19)
    buffer_load_dwordx4 v16, s[8:11], s56 offen offset:2048 nt lds
    s_waitcnt vmcnt(19)
    buffer_load_dwordx4 v17, s[8:11], s56 offen offset:3072 nt lds
    s_waitcnt vmcnt(19)
    v_lshlrev_b32 v6, 1, v2
    v_xor_b32 v5, v3, v6
    v_lshlrev_b32 v5, 4, v5
    v_lshl_add_u32 v18, v2, 8, v5
    v_xor_b32 v19, 0x80, v18
    s_mov_b32 m0, 32768
    s_add_u32 s56, s52, 0
    buffer_load_dwordx4 v18, s[12:15], s56 offen offset:0 nt lds
    s_waitcnt vmcnt(19)
    buffer_load_dwordx4 v19, s[12:15], s56 offen offset:1024 nt lds
    s_waitcnt vmcnt(19)
    buffer_load_dwordx4 v18, s[12:15], s56 offen offset:2048 nt lds
    s_waitcnt vmcnt(19)
    buffer_load_dwordx4 v19, s[12:15], s56 offen offset:3072 nt lds
    s_waitcnt vmcnt(19)
    s_mov_b64 exec, 1
    ds_write_b32 v9, v10 offset:12
    s_mov_b64 exec, -1
    s_mov_b32 m0, 36864
    s_add_u32 s56, s52, 131072
    buffer_load_dwordx4 v18, s[12:15], s56 offen offset:0 nt lds
    s_waitcnt vmcnt(19)
    buffer_load_dwordx4 v19, s[12:15], s56 offen offset:1024 nt lds
    s_waitcnt vmcnt(19)
    buffer_load_dwordx4 v18, s[12:15], s56 offen offset:2048 nt lds
    s_waitcnt vmcnt(19)
    buffer_load_dwordx4 v19, s[12:15], s56 offen offset:3072 nt lds
    s_waitcnt vmcnt(19)
    s_mov_b32 m0, 40960
    s_add_u32 s56, s52, 262144
    buffer_load_dwordx4 v18, s[12:15], s56 offen offset:0 nt lds
    s_waitcnt vmcnt(19)
    buffer_load_dwordx4 v19, s[12:15], s56 offen offset:1024 nt lds
    s_waitcnt vmcnt(19)
    buffer_load_dwordx4 v18, s[12:15], s56 offen offset:2048 nt lds
    s_waitcnt vmcnt(19)
    buffer_load_dwordx4 v19, s[12:15], s56 offen offset:3072 nt lds
    s_waitcnt vmcnt(19)
    s_mov_b32 m0, 45056
    s_add_u32 s56, s52, 393216
    buffer_load_dwordx4 v18, s[12:15], s56 offen offset:0 nt lds
    s_waitcnt vmcnt(19)
    buffer_load_dwordx4 v19, s[12:15], s56 offen offset:1024 nt lds
    s_waitcnt vmcnt(19)
    buffer_load_dwordx4 v18, s[12:15], s56 offen offset:2048 nt lds
    s_waitcnt vmcnt(19)
    buffer_load_dwordx4 v19, s[12:15], s56 offen offset:3072 nt lds
    s_waitcnt vmcnt(19)
    s_mov_b32 m0, 49152
    s_add_u32 s56, s52, 524288
    buffer_load_dwordx4 v18, s[12:15], s56 offen offset:0 nt lds
    s_waitcnt vmcnt(19)
    buffer_load_dwordx4 v19, s[12:15], s56 offen offset:1024 nt lds
    s_waitcnt vmcnt(19)
    buffer_load_dwordx4 v18, s[12:15], s56 offen offset:2048 nt lds
    s_waitcnt vmcnt(19)
    s_mov_b64 exec, 1
    ds_write_b32 v9, v10 offset:8
    s_mov_b64 exec, -1
    buffer_load_dwordx4 v19, s[12:15], s56 offen offset:3072 nt lds
    s_waitcnt vmcnt(19)
    s_mov_b32 m0, 53248
    s_add_u32 s56, s52, 655360
    buffer_load_dwordx4 v18, s[12:15], s56 offen offset:0 nt lds
    s_waitcnt vmcnt(19)
    buffer_load_dwordx4 v19, s[12:15], s56 offen offset:1024 nt lds
    s_waitcnt vmcnt(19)
    buffer_load_dwordx4 v18, s[12:15], s56 offen offset:2048 nt lds
    s_waitcnt vmcnt(19)
    buffer_load_dwordx4 v19, s[12:15], s56 offen offset:3072 nt lds
    s_waitcnt vmcnt(19)
    s_mov_b32 m0, 57344
    s_add_u32 s56, s52, 786432
    buffer_load_dwordx4 v18, s[12:15], s56 offen offset:0 nt lds
    s_waitcnt vmcnt(19)
    buffer_load_dwordx4 v19, s[12:15], s56 offen offset:1024 nt lds
    s_waitcnt vmcnt(19)
    buffer_load_dwordx4 v18, s[12:15], s56 offen offset:2048 nt lds
    s_waitcnt vmcnt(19)
    buffer_load_dwordx4 v19, s[12:15], s56 offen offset:3072 nt lds
    s_waitcnt vmcnt(19)
    s_mov_b32 m0, 61440
    s_add_u32 s56, s52, 917504
    buffer_load_dwordx4 v18, s[12:15], s56 offen offset:0 nt lds
    s_waitcnt vmcnt(19)
    buffer_load_dwordx4 v19, s[12:15], s56 offen offset:1024 nt lds
    s_waitcnt vmcnt(19)
    buffer_load_dwordx4 v18, s[12:15], s56 offen offset:2048 nt lds
    s_waitcnt vmcnt(19)
    buffer_load_dwordx4 v19, s[12:15], s56 offen offset:3072 nt lds
    s_waitcnt vmcnt(19)
    s_waitcnt lgkmcnt(0)
    s_cmp_eq_u32 s44, 7
    s_cselect_b32 s26, 0, 0x1c0000
    s_mov_b32 s30, s26
    s_mov_b32 s34, s26
    s_mov_b32 s27, 0x20000
    s_mov_b32 s31, 0x20000
    s_mov_b32 s35, 0x20000
    v_lshrrev_b32 v6, 3, v1
    v_and_b32 v5, 7, v1
    v_and_b32 v7, 6, v6
    v_xor_b32 v5, v5, v7
    v_lshlrev_b32 v5, 4, v5
    v_mul_u32_u24 v13, 3584, v6
    v_add_u32 v13, v13, v5
    v_lshl_add_u32 v12, v6, 10, v5
    s_and_b32 s57, s45, 7
    s_mul_i32 s57, s57, 229376
    s_lshr_b32 s56, s3, 3
    s_lshl_b32 s56, s56, 7
    s_add_u32 s57, s57, s56
    s_mov_b32 m0, 81920
    s_add_u32 s56, s57, 0
    buffer_load_dwordx4 v13, s[24:27], s56 offen offset:0 nt lds
    s_waitcnt vmcnt(19)
    s_add_u32 s56, s57, 27648
    buffer_load_dwordx4 v13, s[24:27], s56 offen offset:1024 nt lds
    s_waitcnt vmcnt(19)
    s_add_u32 s56, s57, 55296
    buffer_load_dwordx4 v13, s[24:27], s56 offen offset:2048 nt lds
    s_waitcnt vmcnt(19)
    s_add_u32 s56, s57, 82944
    buffer_load_dwordx4 v13, s[24:27], s56 offen offset:3072 nt lds
    s_waitcnt vmcnt(19)
    s_mov_b32 m0, 86016
    s_add_u32 s56, s57, 114688
    buffer_load_dwordx4 v13, s[24:27], s56 offen offset:0 nt lds
    s_waitcnt vmcnt(19)
    s_add_u32 s56, s57, 142336
    buffer_load_dwordx4 v13, s[24:27], s56 offen offset:1024 nt lds
    s_waitcnt vmcnt(19)
    s_add_u32 s56, s57, 169984
    buffer_load_dwordx4 v13, s[24:27], s56 offen offset:2048 nt lds
    s_waitcnt vmcnt(19)
    s_add_u32 s56, s57, 197632
    buffer_load_dwordx4 v13, s[24:27], s56 offen offset:3072 nt lds
    s_waitcnt vmcnt(19)
    s_mov_b32 m0, 90112
    s_add_u32 s56, s57, 0
    buffer_load_dwordx4 v13, s[28:31], s56 offen offset:0 nt lds
    s_waitcnt vmcnt(19)
    s_add_u32 s56, s57, 27648
    buffer_load_dwordx4 v13, s[28:31], s56 offen offset:1024 nt lds
    s_waitcnt vmcnt(19)
    s_add_u32 s56, s57, 55296
    buffer_load_dwordx4 v13, s[28:31], s56 offen offset:2048 nt lds
    s_waitcnt vmcnt(19)
    s_add_u32 s56, s57, 82944
    buffer_load_dwordx4 v13, s[28:31], s56 offen offset:3072 nt lds
    s_waitcnt vmcnt(19)
    s_mov_b32 m0, 94208
    s_add_u32 s56, s57, 114688
    buffer_load_dwordx4 v13, s[28:31], s56 offen offset:0 nt lds
    s_waitcnt vmcnt(19)
    s_add_u32 s56, s57, 142336
    buffer_load_dwordx4 v13, s[28:31], s56 offen offset:1024 nt lds
    s_waitcnt vmcnt(19)
    s_add_u32 s56, s57, 169984
    buffer_load_dwordx4 v13, s[28:31], s56 offen offset:2048 nt lds
    s_waitcnt vmcnt(19)
    s_add_u32 s56, s57, 197632
    buffer_load_dwordx4 v13, s[28:31], s56 offen offset:3072 nt lds
    s_waitcnt vmcnt(19)
    s_lshl_b32 s60, s44, 19
    s_lshr_b32 s56, s45, 3
    s_lshl_b32 s56, s56, 17
    s_add_u32 s60, s60, s56
    s_and_b32 s56, s45, 7
    s_lshl_b32 s56, s56, 7
    s_add_u32 s60, s60, s56
    s_lshr_b32 s61, s3, 3
    s_lshl_b32 s61, s61, 16
    s_add_u32 s61, s61, s56
    s_mov_b32 m0, 98304
    s_add_u32 s56, s60, 0
    buffer_load_dwordx4 v12, s[20:23], s56 offen offset:0 nt lds
    s_waitcnt vmcnt(19)
    s_add_u32 s56, s60, 7168
    buffer_load_dwordx4 v12, s[20:23], s56 offen offset:1024 nt lds
    s_waitcnt vmcnt(19)
    s_add_u32 s56, s60, 14336
    buffer_load_dwordx4 v12, s[20:23], s56 offen offset:2048 nt lds
    s_waitcnt vmcnt(19)
    s_mov_b64 exec, 1
    ds_write_b32 v9, v10 offset:20
    s_mov_b64 exec, -1
    s_add_u32 s56, s60, 21504
    buffer_load_dwordx4 v12, s[20:23], s56 offen offset:3072 nt lds
    s_waitcnt vmcnt(19)
    s_mov_b32 m0, 102400
    s_add_u32 s56, s60, 32768
    buffer_load_dwordx4 v12, s[20:23], s56 offen offset:0 nt lds
    s_waitcnt vmcnt(19)
    s_add_u32 s56, s60, 39936
    buffer_load_dwordx4 v12, s[20:23], s56 offen offset:1024 nt lds
    s_waitcnt vmcnt(19)
    s_add_u32 s56, s60, 47104
    buffer_load_dwordx4 v12, s[20:23], s56 offen offset:2048 nt lds
    s_waitcnt vmcnt(19)
    s_add_u32 s56, s60, 54272
    buffer_load_dwordx4 v12, s[20:23], s56 offen offset:3072 nt lds
    s_waitcnt vmcnt(19)
    s_mov_b32 m0, 106496
    s_add_u32 s56, s60, 65536
    buffer_load_dwordx4 v12, s[20:23], s56 offen offset:0 nt lds
    s_waitcnt vmcnt(19)
    s_add_u32 s56, s60, 72704
    buffer_load_dwordx4 v12, s[20:23], s56 offen offset:1024 nt lds
    s_waitcnt vmcnt(19)
    s_add_u32 s56, s60, 79872
    buffer_load_dwordx4 v12, s[20:23], s56 offen offset:2048 nt lds
    s_waitcnt vmcnt(19)
    s_add_u32 s56, s60, 87040
    buffer_load_dwordx4 v12, s[20:23], s56 offen offset:3072 nt lds
    s_waitcnt vmcnt(19)
    s_mov_b32 m0, 110592
    s_add_u32 s56, s60, 98304
    buffer_load_dwordx4 v12, s[20:23], s56 offen offset:0 nt lds
    s_waitcnt vmcnt(19)
    s_add_u32 s56, s60, 105472
    buffer_load_dwordx4 v12, s[20:23], s56 offen offset:1024 nt lds
    s_waitcnt vmcnt(19)
    s_add_u32 s56, s60, 112640
    buffer_load_dwordx4 v12, s[20:23], s56 offen offset:2048 nt lds
    s_waitcnt vmcnt(19)
    s_add_u32 s56, s60, 119808
    buffer_load_dwordx4 v12, s[20:23], s56 offen offset:3072 nt lds
    s_waitcnt vmcnt(19)
    s_mov_b32 m0, 114688
    s_add_u32 s56, s61, 0
    buffer_load_dwordx4 v12, s[32:35], s56 offen offset:0 nt lds
    s_waitcnt vmcnt(19)
    s_add_u32 s56, s61, 7168
    buffer_load_dwordx4 v12, s[32:35], s56 offen offset:1024 nt lds
    s_waitcnt vmcnt(19)
    s_add_u32 s56, s61, 14336
    buffer_load_dwordx4 v12, s[32:35], s56 offen offset:2048 nt lds
    s_waitcnt vmcnt(19)
    s_mov_b64 exec, 1
    ds_write_b32 v9, v10 offset:24
    s_mov_b64 exec, -1
    s_add_u32 s56, s61, 21504
    buffer_load_dwordx4 v12, s[32:35], s56 offen offset:3072 nt lds
    s_waitcnt vmcnt(19)
    s_mov_b32 m0, 118784
    s_add_u32 s56, s61, 32768
    buffer_load_dwordx4 v12, s[32:35], s56 offen offset:0 nt lds
    s_waitcnt vmcnt(19)
    s_add_u32 s56, s61, 39936
    buffer_load_dwordx4 v12, s[32:35], s56 offen offset:1024 nt lds
    s_waitcnt vmcnt(19)
    s_add_u32 s56, s61, 47104
    buffer_load_dwordx4 v12, s[32:35], s56 offen offset:2048 nt lds
    s_waitcnt vmcnt(19)
    s_add_u32 s56, s61, 54272
    buffer_load_dwordx4 v12, s[32:35], s56 offen offset:3072 nt lds
    v_lshrrev_b32 v5, 1, v1
    v_and_b32 v6, 7, v5
    v_lshrrev_b32 v5, 3, v5
    v_lshl_add_u32 v5, v5, 6, v6
    v_lshlrev_b32 v20, 8, v5
    v_and_b32 v6, 1, v1
    v_lshl_add_u32 v20, v6, 5, v20
    v_lshlrev_b32 v21, 4, v6
    v_lshrrev_b32 v5, 1, v2
    v_lshl_add_u32 v21, v5, 3, v21
    v_and_b32 v5, 1, v2
    v_lshl_add_u32 v21, v5, 2, v21
    s_and_b32 s54, s45, 7
    s_lshr_b32 s55, s45, 3
    s_lshl_b32 s57, s54, 7
    s_lshl_b32 s60, s55, 5
    s_add_u32 s57, s57, s60
    v_add_u32 v21, s57, v21
    s_lshl_b32 s57, s54, 11
    s_lshl_b32 s60, s55, 6
    s_add_u32 s57, s57, s60
    s_add_u32 s57, s57, 1048576
    s_waitcnt vmcnt(17)
    s_mov_b64 exec, 1
    ds_write_b32 v9, v10 offset:28
    s_mov_b64 exec, -1
    s_waitcnt vmcnt(0)
    s_mov_b64 exec, 1
    ds_write_b32 v9, v10 offset:44
    s_mov_b64 exec, -1
    s_cmp_lg_u32 s54, s44
    s_cbranch_scc1 L_fin
    v_add_u32 v5, 122880, v21
    ds_read_b32 v22, v5
    s_mov_b32 s58, 1600000
L_fw0:
    ds_read_b32 v8, v9 offset:52
    s_waitcnt lgkmcnt(0)
    v_readfirstlane_b32 s53, v8
    s_nop 0
    s_cmp_ge_u32 s53, 4
    s_cbranch_scc1 L_fd0
    s_sub_u32 s58, s58, 1
    s_cbranch_scc0 L_fw0
L_fd0:
    ds_read_b32 v7, v9 offset:56
    s_waitcnt lgkmcnt(0)
    v_readfirstlane_b32 s47, v7
    buffer_load_dwordx4 v[24:27], v20, s[40:43], s57 offen sc1
    buffer_load_dwordx4 v[28:31], v20, s[40:43], s57 offen offset:16 sc1
    s_mul_i32 s48, s47, 0x9b1
    s_add_u32 s48, s48, 0x1f3
    s_and_b32 s48, s48, 0xfff
    s_mul_i32 s49, s47, 0x3c5
    s_add_u32 s49, s49, 0x8a5
    s_and_b32 s49, s49, 0xfff
    s_mul_i32 s50, s47, 0x6a7
    s_add_u32 s50, s50, 0x417
    s_and_b32 s50, s50, 0xfff
    s_mul_i32 s51, s47, 0xd2b
    s_add_u32 s51, s51, 0xc69
    s_and_b32 s51, s51, 0xfff
    s_mov_b32 s58, 200000
    s_waitcnt vmcnt(0)
    s_branch L_chk1
L_poll1:
    buffer_load_dwordx4 v[24:27], v20, s[40:43], s57 offen sc1
    buffer_load_dwordx4 v[28:31], v20, s[40:43], s57 offen offset:16 sc1
    s_waitcnt vmcnt(0)
L_chk1:
    v_xor_b32 v24, s48, v24
    v_xor_b32 v25, s49, v25
    v_xor_b32 v26, s50, v26
    v_xor_b32 v27, s51, v27
    v_xor_b32 v28, s48, v28
    v_xor_b32 v29, s49, v29
    v_xor_b32 v30, s50, v30
    v_xor_b32 v31, s51, v31
    v_or3_b32 v5, v24, v25, v26
    v_or3_b32 v6, v27, v28, v29
    v_or3_b32 v5, v5, v30, v31
    v_or_b32 v5, v5, v6
    v_and_b32 v5, 0xfff, v5
    v_cmp_ne_u32 vcc, 0, v5
    s_nop 0
    s_mov_b64 exec, vcc
    s_cbranch_execz L_ok1
    s_sub_u32 s58, s58, 1
    s_cbranch_scc0 L_poll1
L_ok1:
    s_mov_b64 exec, -1
    s_nop 0
    v_permlane32_swap_b32 v24, v28
    v_permlane32_swap_b32 v25, v29
    v_permlane32_swap_b32 v26, v30
    v_permlane32_swap_b32 v27, v31
    v_add_f32 v24, v24, v28
    v_add_f32 v25, v25, v29
    v_add_f32 v26, v26, v30
    v_add_f32 v27, v27, v31
    s_nop 0
    v_permlane16_swap_b32 v24, v26
    v_permlane16_swap_b32 v25, v27
    v_add_f32 v24, v24, v26
    v_add_f32 v25, v25, v27
    s_nop 0
    v_add_f32_dpp v24, v24, v24 row_ror:8 row_mask:0xf bank_mask:0xf
    v_add_f32_dpp v25, v25, v25 row_ror:8 row_mask:0xf bank_mask:0xf
    s_nop 0
    v_add_f32_dpp v24, v24, v24 row_ror:4 row_mask:0xf bank_mask:0xf
    v_add_f32_dpp v25, v25, v25 row_ror:4 row_mask:0xf bank_mask:0xf
    s_nop 0
    v_add_f32_dpp v24, v24, v24 row_ror:2 row_mask:0xf bank_mask:0xf
    v_add_f32_dpp v25, v25, v25 row_ror:2 row_mask:0xf bank_mask:0xf
    v_lshlrev_b32 v5, 16, v22
    v_and_b32 v6, 0xffff0000, v22
    v_add_f32 v24, v24, v5
    v_add_f32 v25, v25, v6
    v_cvt_pk_bf16_f32 v24, v24, v25
    s_mov_b32 exec_lo, 0x30003
    s_mov_b32 exec_hi, 0x30003
    buffer_store_dword v24, v21, s[36:39], 0 offen
    s_cmp_lg_u32 s59, 0
    s_cbranch_scc1 L_fin
    s_add_u32 s54, s47, 1
    s_mov_b64 exec, 1
    v_mov_b32 v5, s54
    v_mov_b32 v6, 0
    buffer_store_dword v5, v6, s[40:43], 0 offen sc1
    s_branch L_fin
L_compute:
    v_lshrrev_b32 v2, 4, v1
    v_and_b32 v3, 15, v1
    v_mov_b32 v9, 127680
    v_mov_b32 v10, 1
    s_lshl_b32 s59, s44, 5
    s_add_u32 s59, s59, s45
    s_cmp_gt_u32 s44, 7
    s_cselect_b32 s3, 1, 0
    s_sub_u32 s3, s44, s3
    s_cmp_eq_u32 s44, 7
    s_cselect_b32 s3, 7, s3
    s_lshl_b32 s3, s3, 5
    s_add_u32 s3, s3, s45
    v_mov_b32 v5, 0
    v_and_b32 v6, 31, v1
    v_lshlrev_b32 v6, 2, v6
    v_add_u32 v6, 127680, v6
    ds_write_b32 v6, v5
    v_mov_b32 v4, 0xfffff000
    s_mov_b32 s42, 0x400000
    s_mov_b32 s43, 0x20000
    s_waitcnt lgkmcnt(0)
    s_load_dword s47, s[40:41], 0
    s_barrier
    v_lshlrev_b32 v11, 4, v1
    v_lshrrev_b32 v5, 2, v1
    v_lshlrev_b32 v12, 7, v5
    v_lshrrev_b32 v6, 1, v5
    v_and_b32 v6, 3, v6
    v_xor_b32 v6, s46, v6
    v_lshl_add_u32 v12, v6, 5, v12
    v_and_b32 v6, 3, v1
    v_lshl_add_u32 v12, v6, 3, v12
    v_add_u32 v12, 65536, v12
    s_lshr_b32 s54, s45, 3
    s_lshl_b32 s54, s54, 8
    s_add_u32 s54, s54, 123904
    v_lshl_add_u32 v13, v2, 3, s54
    v_lshrrev_b32 v5, 5, v1
    v_and_b32 v6, 31, v1
    v_lshlrev_b32 v7, 4, v6
    v_lshl_add_u32 v14, v5, 12, v7
    v_lshlrev_b32 v6, 3, v6
    v_lshl_add_u32 v15, v5, 2, v6
    s_mul_i32 s54, s46, 320
    s_add_u32 s54, s54, 124928
    v_add_u32 v15, s54, v15
    v_and_b32 v5, 3, v3
    v_mul_u32_u24 v16, 320, v5
    v_lshl_add_u32 v16, v2, 4, v16
    v_add_u32 v16, 124928, v16
    v_lshlrev_b32 v17, 4, v5
    v_add_u32 v17, 126208, v17
    s_lshl_b32 s54, s46, 2
    v_add_u32 v18, s54, v17
    v_lshlrev_b32 v19, 4, v5
    v_lshl_add_u32 v19, v2, 6, v19
    v_add_u32 v19, 126272, v19
    s_lshl_b32 s54, s46, 8
    v_add_u32 v20, s54, v19
    v_lshlrev_b32 v21, 9, v5
    v_lshl_add_u32 v21, v2, 4, v21
    v_lshrrev_b32 v6, 2, v3
    v_and_b32 v6, 1, v6
    v_lshl_add_u32 v21, v6, 6, v21
    s_lshl_b32 s54, s46, 7
    v_add_u32 v21, s54, v21
    s_lshl_b32 s60, s46, 13
    v_xor_b32 v5, v2, v3
    v_lshlrev_b32 v5, 4, v5
    v_lshl_add_u32 v22, v3, 8, v5
    v_add_u32 v22, s60, v22
    v_xor_b32 v23, 0x40, v22
    v_xor_b32 v24, 0x80, v22
    v_xor_b32 v25, 0xc0, v22
    v_lshrrev_b32 v6, 2, v1
    v_lshlrev_b32 v26, 8, v6
    v_and_b32 v6, 7, v6
    s_lshl_b32 s54, s46, 1
    v_xor_b32 v6, s54, v6
    v_lshl_add_u32 v26, v6, 5, v26
    v_and_b32 v6, 3, v1
    v_lshl_add_u32 v26, v6, 3, v26
    v_add_u32 v26, 32768, v26
    v_xor_b32 v27, 32, v26
    v_lshlrev_b32 v28, 5, v2
    v_lshl_add_u32 v28, v3, 4, v28
    s_mov_b32 s58, 1600000
L_fw2:
    ds_read_b32 v8, v9 offset:0
    s_waitcnt lgkmcnt(0)
    v_readfirstlane_b32 s53, v8
    s_nop 0
    s_cmp_ge_u32 s53, 1
    s_cbranch_scc1 L_fd2
    s_sub_u32 s58, s58, 1
    s_cbranch_scc0 L_fw2
L_fd2:
    v_add_u32 v5, 122880, v11
    ds_read_b128 v[52:55], v5
    s_waitcnt lgkmcnt(0)
    v_lshlrev_b32 v36, 16, v52
    v_and_b32 v37, 0xffff0000, v52
    v_lshlrev_b32 v38, 16, v53
    v_and_b32 v39, 0xffff0000, v53
    v_lshlrev_b32 v40, 16, v54
    v_and_b32 v41, 0xffff0000, v54
    v_lshlrev_b32 v42, 16, v55
    v_and_b32 v43, 0xffff0000, v55
    v_readlane_b32 s54, v36, 0
    s_nop 1
    v_subrev_f32 v44, s54, v36
    v_subrev_f32 v45, s54, v37
    v_subrev_f32 v46, s54, v38
    v_subrev_f32 v47, s54, v39
    v_subrev_f32 v48, s54, v40
    v_subrev_f32 v49, s54, v41
    v_subrev_f32 v50, s54, v42
    v_subrev_f32 v51, s54, v43
    v_add_f32 v5, v44, v45
    v_mul_f32 v6, v44, v44
    v_add_f32 v7, v46, v47
    v_fmac_f32 v6, v45, v45
    v_add_f32 v8, v48, v49
    v_fmac_f32 v6, v46, v46
    v_add_f32 v5, v5, v7
    v_fmac_f32 v6, v47, v47
    v_add_f32 v7, v50, v51
    v_fmac_f32 v6, v48, v48
    v_add_f32 v8, v8, v7
    v_fmac_f32 v6, v49, v49
    v_add_f32 v5, v5, v8
    v_fmac_f32 v6, v50, v50
    v_fmac_f32 v6, v51, v51
    v_add_f32_dpp v5, v5, v5 quad_perm:[1,0,3,2] row_mask:0xf bank_mask:0xf
    s_nop 0
    v_add_f32_dpp v6, v6, v6 quad_perm:[1,0,3,2] row_mask:0xf bank_mask:0xf
    v_add_f32_dpp v5, v5, v5 quad_perm:[2,3,0,1] row_mask:0xf bank_mask:0xf
    s_nop 0
    v_add_f32_dpp v6, v6, v6 quad_perm:[2,3,0,1] row_mask:0xf bank_mask:0xf
    v_add_f32_dpp v5, v5, v5 row_half_mirror row_mask:0xf bank_mask:0xf
    s_nop 0
    v_add_f32_dpp v6, v6, v6 row_half_mirror row_mask:0xf bank_mask:0xf
    v_add_f32_dpp v5, v5, v5 row_mirror row_mask:0xf bank_mask:0xf
    s_nop 0
    v_add_f32_dpp v6, v6, v6 row_mirror row_mask:0xf bank_mask:0xf
    v_add_f32_dpp v5, v5, v5 row_bcast:15 row_mask:0xa bank_mask:0xf
    s_nop 0
    v_add_f32_dpp v6, v6, v6 row_bcast:15 row_mask:0xa bank_mask:0xf
    v_add_f32_dpp v5, v5, v5 row_bcast:31 row_mask:0xc bank_mask:0xf
    s_nop 0
    v_add_f32_dpp v6, v6, v6 row_bcast:31 row_mask:0xc bank_mask:0xf
    v_readlane_b32 s55, v5, 63
    v_readlane_b32 s56, v6, 63
    v_mov_b32 v7, 0x3b000000
    v_mul_f32 v5, s55, v7
    v_mul_f32 v6, s56, v7
    v_fma_f32 v6, -v5, v5, v6
    v_add_f32 v5, s54, v5
    v_max_f32 v6, 0, v6
    v_cvt_pk_bf16_f32 v5, v5, v6
    v_and_b32 v7, 0xffff0000, v5
    v_lshlrev_b32 v6, 16, v5
    v_add_f32 v7, 0x3727c5ac, v7
    v_sub_f32 v44, v36, v6
    v_sub_f32 v45, v37, v6
    v_sub_f32 v46, v38, v6
    v_sub_f32 v47, v39, v6
    v_sub_f32 v48, v40, v6
    v_sub_f32 v49, v41, v6
    v_sub_f32 v50, v42, v6
    v_sub_f32 v51, v43, v6
    v_cvt_pk_bf16_f32 v7, v7, v7
    v_and_b32 v7, 0xffff0000, v7
    v_sqrt_f32 v7, v7
    v_cvt_pk_bf16_f32 v36, v44, v45
    v_cvt_pk_bf16_f32 v37, v46, v47
    v_cvt_pk_bf16_f32 v38, v48, v49
    v_cvt_pk_bf16_f32 v39, v50, v51
    v_cvt_pk_bf16_f32 v7, v7, v7
    v_and_b32 v7, 0xffff0000, v7
    v_rcp_f32 v7, v7
    v_lshlrev_b32 v44, 16, v36
    v_and_b32 v45, 0xffff0000, v36
    v_lshlrev_b32 v46, 16, v37
    v_and_b32 v47, 0xffff0000, v37
    v_lshlrev_b32 v48, 16, v38
    v_and_b32 v49, 0xffff0000, v38
    v_lshlrev_b32 v50, 16, v39
    v_and_b32 v51, 0xffff0000, v39
    v_mul_f32 v44, v44, v7
    v_mul_f32 v45, v45, v7
    v_mul_f32 v46, v46, v7
    v_mul_f32 v47, v47, v7
    v_mul_f32 v48, v48, v7
    v_mul_f32 v49, v49, v7
    v_mul_f32 v50, v50, v7
    v_mul_f32 v51, v51, v7
    v_cvt_pk_bf16_f32 v36, v44, v45
    v_cvt_pk_bf16_f32 v37, v46, v47
    v_cvt_pk_bf16_f32 v38, v48, v49
    v_cvt_pk_bf16_f32 v39, v50, v51
    v_add_u32 v5, 123904, v11
    ds_write_b128 v5, v[36:39]
    s_waitcnt lgkmcnt(0)
    s_mul_i32 s48, s47, 0x9b1
    s_add_u32 s48, s48, 0x1f3
    s_and_b32 s48, s48, 0xfff
    s_mul_i32 s49, s47, 0x3c5
    s_add_u32 s49, s49, 0x8a5
    s_and_b32 s49, s49, 0xfff
    s_mul_i32 s50, s47, 0x6a7
    s_add_u32 s50, s50, 0x417
    s_and_b32 s50, s50, 0xfff
    s_mul_i32 s51, s47, 0xd2b
    s_add_u32 s51, s51, 0xc69
    s_and_b32 s51, s51, 0xfff
    v_mov_b32 v5, s47
    s_mov_b64 exec, 1
    ds_write_b32 v9, v5 offset:56
    s_mov_b64 exec, -1
    s_getreg_b32 s63, hwreg(HW_REG_XCC_ID, 0, 4)
    s_and_b32 s62, s51, 0xff0
    s_or_b32 s62, s62, s63
    ds_read2_b64 v[52:55], v13 offset0:0 offset1:4
    ds_read2_b64 v[56:59], v13 offset0:8 offset1:12
    ds_read2_b64 v[60:63], v13 offset0:16 offset1:20
    ds_read2_b64 v[64:67], v13 offset0:24 offset1:28
    s_lshl_b32 s54, s44, 13
    s_lshr_b32 s55, s45, 3
    s_lshl_b32 s55, s55, 11
    s_add_u32 s54, s54, s55
    s_and_b32 s55, s45, 7
    s_lshl_b32 s55, s55, 8
    s_add_u32 s54, s54, s55
    s_lshl_b32 s55, s46, 6
    s_add_u32 s54, s54, s55
    s_add_u32 s54, s54, 65536
    s_lshl_b32 s57, s44, 13
    s_lshl_b32 s55, s46, 9
    s_add_u32 s57, s57, s55
    s_add_u32 s57, s57, 65536
    s_mov_b32 s58, 1600000
L_fw3:
    ds_read_b32 v8, v9 offset:4
    s_waitcnt lgkmcnt(0)
    v_readfirstlane_b32 s53, v8
    s_nop 0
    s_cmp_ge_u32 s53, 1
    s_cbranch_scc1 L_fd3
    s_sub_u32 s58, s58, 1
    s_cbranch_scc0 L_fw3
L_fd3:
    ds_read_b64_tr_b16 v[36:37], v12 offset:0
    ds_read_b64_tr_b16 v[38:39], v12 offset:2048
    ds_read_b64_tr_b16 v[40:41], v12 offset:4096
    ds_read_b64_tr_b16 v[42:43], v12 offset:6144
    ds_read_b64_tr_b16 v[44:45], v12 offset:8192
    ds_read_b64_tr_b16 v[46:47], v12 offset:10240
    ds_read_b64_tr_b16 v[48:49], v12 offset:12288
    ds_read_b64_tr_b16 v[50:51], v12 offset:14336
    v_lshlrev_b32 v5, 4, v2
    s_waitcnt lgkmcnt(6)
    v_mfma_f32_16x16x32_bf16 v[68:71], v[36:39], v[52:55], 0
    s_waitcnt lgkmcnt(4)
    v_mfma_f32_16x16x32_bf16 v[68:71], v[40:43], v[56:59], v[68:71]
    s_waitcnt lgkmcnt(2)
    v_mfma_f32_16x16x32_bf16 v[68:71], v[44:47], v[60:63], v[68:71]
    s_waitcnt lgkmcnt(0)
    v_mfma_f32_16x16x32_bf16 v[68:71], v[48:51], v[64:67], v[68:71]
    s_nop 7
    v_and_or_b32 v76, v68, v4, s48
    v_and_or_b32 v77, v69, v4, s49
    v_and_or_b32 v78, v70, v4, s50
    v_and_or_b32 v79, v71, v4, s62
    s_mov_b32 exec_lo, 0x10001
    s_mov_b32 exec_hi, 0x10001
    s_add_u32 s55, s54, 262144
    buffer_store_dwordx4 v[76:79], v5, s[40:43], s55 offen
    buffer_store_dwordx4 v[76:79], v5, s[40:43], s54 offen sc1
    s_mov_b64 exec, -1
    v_mov_b32 v168, 0x3f803f80
    v_mov_b32 v169, 0x3f803f80
    v_mov_b32 v170, 0x3f803f80
    v_mov_b32 v171, 0x3f803f80
    s_mov_b32 s58, 1600000
L_fw4:
    ds_read_b32 v8, v9 offset:12
    s_waitcnt lgkmcnt(0)
    v_readfirstlane_b32 s53, v8
    s_nop 0
    s_cmp_ge_u32 s53, 1
    s_cbranch_scc1 L_fd4
    s_sub_u32 s58, s58, 1
    s_cbranch_scc0 L_fw4
L_fd4:
    s_add_u32 s55, s57, 262144
    buffer_load_dwordx4 v[80:83], v14, s[40:43], s55 offen sc1
    buffer_load_dwordx4 v[84:87], v14, s[40:43], s55 offen offset:2048 sc1
    s_mov_b32 s58, 1600000
L_fw6:
    ds_read_b32 v8, v9 offset:8
    s_waitcnt lgkmcnt(0)
    v_readfirstlane_b32 s53, v8
    s_nop 0
    s_cmp_ge_u32 s53, 1
    s_cbranch_scc1 L_fd6
    s_sub_u32 s58, s58, 1
    s_cbranch_scc0 L_fw6
L_fd6:
    ds_read_b128 v[88:91], v22 offset:0
    ds_read_b128 v[92:95], v23 offset:0
    ds_read_b128 v[96:99], v24 offset:0
    ds_read_b128 v[100:103], v25 offset:0
    ds_read_b128 v[104:107], v22 offset:4096
    ds_read_b128 v[108:111], v23 offset:4096
    ds_read_b128 v[112:115], v24 offset:4096
    ds_read_b128 v[116:119], v25 offset:4096
    s_mov_b32 s58, 200000
    s_waitcnt vmcnt(0)
    s_branch L_chk5
L_poll5:
    buffer_load_dwordx4 v[80:83], v14, s[40:43], s55 offen sc1
    buffer_load_dwordx4 v[84:87], v14, s[40:43], s55 offen offset:2048 sc1
    s_mov_b32 s55, s57
    s_waitcnt vmcnt(0)
L_chk5:
    v_xor_b32 v80, s48, v80
    v_xor_b32 v81, s49, v81
    v_xor_b32 v82, s50, v82
    v_xor_b32 v83, s62, v83
    v_xor_b32 v84, s48, v84
    v_xor_b32 v85, s49, v85
    v_xor_b32 v86, s50, v86
    v_xor_b32 v87, s62, v87
    v_or3_b32 v5, v80, v81, v82
    v_or_b32 v6, v83, v87
    v_or3_b32 v5, v5, v84, v85
    v_and_b32 v7, 0xff0, v6
    v_or3_b32 v5, v5, v86, v7
    v_and_b32 v5, 0xfff, v5
    v_cmp_ne_u32 vcc, 0, v5
    s_nop 0
    s_mov_b64 exec, vcc
    s_cbranch_execz L_ok5
    s_sub_u32 s58, s58, 1
    s_cbranch_scc0 L_poll5
L_ok5:
    s_mov_b64 exec, -1
    v_or_b32 v6, v83, v87
    v_and_b32 v6, 15, v6
    v_and_b32 v83, v4, v83
    v_cmp_ne_u32 vcc, 0, v6
    v_and_b32 v87, v4, v87
    s_cbranch_vccz L_same
    s_mov_b64 exec, 1
    ds_write_b32 v9, v10 offset:36
    s_mov_b64 exec, -1
L_same:
    v_add_f32 v80, v80, v84
    v_add_f32 v81, v81, v85
    v_add_f32 v82, v82, v86
    v_add_f32 v83, v83, v87
    s_nop 0
    v_permlane32_swap_b32 v80, v82
    v_permlane32_swap_b32 v81, v83
    v_add_f32 v80, v80, v82
    v_add_f32 v81, v81, v83
    v_cvt_pk_bf16_f32 v80, v80, v81
    ds_write_b32 v15, v80
    s_mov_b64 exec, 1
    ds_add_u32 v9, v10 offset:32
    s_mov_b64 exec, -1
    s_mov_b32 s58, 1600000
L_fw7:
    ds_read_b64 v[30:31], v9 offset:32
    s_waitcnt lgkmcnt(0)
    v_readfirstlane_b32 s53, v30
    v_readfirstlane_b32 s63, v31
    s_cmp_ge_u32 s53, 4
    s_cbranch_scc1 L_fd7
    s_sub_u32 s58, s58, 1
    s_cbranch_scc0 L_fw7
L_fd7:
    ds_read_b128 v[52:55], v16 offset:0
    ds_read_b128 v[56:59], v16 offset:64
    ds_read_b128 v[60:63], v16 offset:128
    ds_read_b128 v[64:67], v16 offset:192
    s_waitcnt lgkmcnt(3)
    v_mfma_f32_16x16x32_bf16 v[152:155], v[88:91], v[52:55], 0
    v_mfma_f32_16x16x32_bf16 v[156:159], v[104:107], v[52:55], 0
    s_waitcnt lgkmcnt(2)
    v_mfma_f32_16x16x32_bf16 v[152:155], v[92:95], v[56:59], v[152:155]
    v_mfma_f32_16x16x32_bf16 v[156:159], v[108:111], v[56:59], v[156:159]
    s_waitcnt lgkmcnt(1)
    v_mfma_f32_16x16x32_bf16 v[152:155], v[96:99], v[60:63], v[152:155]
    v_mfma_f32_16x16x32_bf16 v[156:159], v[112:115], v[60:63], v[156:159]
    s_waitcnt lgkmcnt(0)
    v_mfma_f32_16x16x32_bf16 v[152:155], v[100:103], v[64:67], v[152:155]
    v_mfma_f32_16x16x32_bf16 v[156:159], v[116:119], v[64:67], v[156:159]
    s_nop 6
    v_max3_f32 v160, v152, v153, v154
    v_max3_f32 v161, v155, v156, v157
    v_max3_f32 v160, v160, v158, v159
    v_max_f32 v160, v160, v161
    v_mov_b32 v161, v160
    s_nop 1
    v_permlane16_swap_b32 v160, v161
    v_max_f32 v160, v160, v161
    v_mov_b32 v161, v160
    s_nop 1
    v_permlane32_swap_b32 v160, v161
    v_max_f32 v160, v160, v161
    s_mov_b32 exec_lo, 0xf
    s_mov_b32 exec_hi, 0x0
    ds_write_b32 v18, v160
    s_mov_b64 exec, 1
    ds_add_u32 v9, v10 offset:40
    s_mov_b64 exec, -1
    s_mov_b32 s54, 0x3e0293ee
    s_mov_b32 s58, 1600000
L_fw8:
    ds_read_b32 v8, v9 offset:40
    s_waitcnt lgkmcnt(0)
    v_readfirstlane_b32 s53, v8
    s_nop 0
    s_cmp_ge_u32 s53, 4
    s_cbranch_scc1 L_fd8
    s_sub_u32 s58, s58, 1
    s_cbranch_scc0 L_fw8
L_fd8:
    ds_read_b128 v[172:175], v17
    s_waitcnt lgkmcnt(0)
    v_max3_f32 v160, v172, v173, v174
    v_max_f32 v160, v160, v175
    v_mul_f32 v160, s54, v160
    v_and_b32 v160, v4, v160
    v_fma_f32 v152, v152, s54, -v160
    v_fma_f32 v153, v153, s54, -v160
    v_fma_f32 v154, v154, s54, -v160
    v_fma_f32 v155, v155, s54, -v160
    v_fma_f32 v156, v156, s54, -v160
    v_fma_f32 v157, v157, s54, -v160
    v_fma_f32 v158, v158, s54, -v160
    v_fma_f32 v159, v159, s54, -v160
    v_exp_f32 v152, v152
    v_exp_f32 v153, v153
    v_exp_f32 v154, v154
    v_exp_f32 v155, v155
    v_exp_f32 v156, v156
    v_exp_f32 v157, v157
    v_exp_f32 v158, v158
    v_exp_f32 v159, v159
    v_cvt_pk_bf16_f32 v164, v152, v153
    v_cvt_pk_bf16_f32 v165, v154, v155
    v_cvt_pk_bf16_f32 v166, v156, v157
    v_cvt_pk_bf16_f32 v167, v158, v159
    s_mov_b32 exec_lo, 0xf000f
    s_mov_b32 exec_hi, 0xf000f
    ds_write_b128 v20, v[164:167]
    s_mov_b64 exec, 1
    ds_add_u32 v9, v10 offset:16
    s_mov_b64 exec, -1
    s_lshl_b32 s54, s59, 11
    s_add_u32 s54, s54, 524288
    s_lshl_b32 s57, s59, 6
    s_add_u32 s57, s57, 262144
    v_lshrrev_b32 v5, 2, v3
    v_and_b32 v5, 1, v5
    v_cmp_eq_u32 s[60:61], 1, v5
    v_lshlrev_b32 v7, 4, v3
    s_mov_b32 s58, 1600000
L_fw9:
    ds_read_b128 v[32:35], v9 offset:16
    s_waitcnt lgkmcnt(0)
    v_readfirstlane_b32 s53, v32
    v_readfirstlane_b32 s96, v33
    v_readfirstlane_b32 s97, v34
    v_readfirstlane_b32 s98, v35
    s_cmp_ge_u32 s53, 4
    s_cbranch_scc1 L_fd9
    s_sub_u32 s58, s58, 1
    s_cbranch_scc0 L_fw9
L_fd9:
    ds_read_b128 v[88:91], v19 offset:0
    ds_read_b128 v[92:95], v19 offset:256
    ds_read_b128 v[96:99], v19 offset:512
    ds_read_b128 v[100:103], v19 offset:768
    s_waitcnt lgkmcnt(3)
    v_mfma_f32_16x16x32_bf16 v[172:175], v[168:171], v[88:91], 0
    s_waitcnt lgkmcnt(2)
    v_mfma_f32_16x16x32_bf16 v[172:175], v[168:171], v[92:95], v[172:175]
    s_waitcnt lgkmcnt(1)
    v_mfma_f32_16x16x32_bf16 v[172:175], v[168:171], v[96:99], v[172:175]
    s_waitcnt lgkmcnt(0)
    v_mfma_f32_16x16x32_bf16 v[172:175], v[168:171], v[100:103], v[172:175]
    s_cmp_lg_u32 s46, 0
    s_cbranch_scc1 L_nostat
    v_or_b32 v112, s48, v160
    s_nop 4
    v_and_or_b32 v113, v172, v4, s49
    v_mov_b32 v114, s50
    v_mov_b32 v115, s51
    s_mov_b32 exec_lo, 0xf
    s_mov_b32 exec_hi, 0
    s_cmp_lg_u32 s63, 0
    s_cbranch_scc1 L_far_st
    buffer_store_dwordx4 v[112:115], v7, s[40:43], s57 offen
    s_branch L_done_st
L_far_st:
    buffer_store_dwordx4 v[112:115], v7, s[40:43], s57 offen sc1
L_done_st:
    s_mov_b64 exec, -1
L_nostat:
    s_cmp_ge_u32 s96, 1
    s_cbranch_scc1 L_fd10
    s_mov_b32 s58, 1600000
L_fw10:
    ds_read_b128 v[32:35], v9 offset:16
    s_waitcnt lgkmcnt(0)
    v_readfirstlane_b32 s96, v33
    v_readfirstlane_b32 s97, v34
    v_readfirstlane_b32 s98, v35
    s_cmp_ge_u32 s96, 1
    s_cbranch_scc1 L_fd10
    s_sub_u32 s58, s58, 1
    s_cbranch_scc0 L_fw10
L_fd10:
    ds_read_b64_tr_b16 v[120:121], v26 offset:0
    ds_read_b64_tr_b16 v[122:123], v26 offset:4096
    ds_read_b64_tr_b16 v[124:125], v27 offset:0
    ds_read_b64_tr_b16 v[126:127], v27 offset:4096
    ds_read_b64_tr_b16 v[128:129], v26 offset:8192
    ds_read_b64_tr_b16 v[130:131], v26 offset:12288
    ds_read_b64_tr_b16 v[132:133], v27 offset:8192
    ds_read_b64_tr_b16 v[134:135], v27 offset:12288
    ds_read_b64_tr_b16 v[136:137], v26 offset:16384
    ds_read_b64_tr_b16 v[138:139], v26 offset:20480
    ds_read_b64_tr_b16 v[140:141], v27 offset:16384
    ds_read_b64_tr_b16 v[142:143], v27 offset:20480
    ds_read_b64_tr_b16 v[144:145], v26 offset:24576
    ds_read_b64_tr_b16 v[146:147], v26 offset:28672
    ds_read_b64_tr_b16 v[148:149], v27 offset:24576
    ds_read_b64_tr_b16 v[150:151], v27 offset:28672
    s_waitcnt lgkmcnt(12)
    v_mfma_f32_16x16x32_bf16 v[104:107], v[120:123], v[88:91], 0
    v_mfma_f32_16x16x32_bf16 v[108:111], v[124:127], v[88:91], 0
    s_waitcnt lgkmcnt(8)
    v_mfma_f32_16x16x32_bf16 v[104:107], v[128:131], v[92:95], v[104:107]
    v_mfma_f32_16x16x32_bf16 v[108:111], v[132:135], v[92:95], v[108:111]
    s_waitcnt lgkmcnt(4)
    v_mfma_f32_16x16x32_bf16 v[104:107], v[136:139], v[96:99], v[104:107]
    v_mfma_f32_16x16x32_bf16 v[108:111], v[140:143], v[96:99], v[108:111]
    s_waitcnt lgkmcnt(0)
    v_mfma_f32_16x16x32_bf16 v[104:107], v[144:147], v[100:103], v[104:107]
    v_mfma_f32_16x16x32_bf16 v[108:111], v[148:151], v[100:103], v[108:111]
    s_nop 7
    v_cndmask_b32 v76, v104, v108, s[60:61]
    v_cndmask_b32 v77, v105, v109, s[60:61]
    v_cndmask_b32 v78, v106, v110, s[60:61]
    v_cndmask_b32 v79, v107, v111, s[60:61]
    v_and_or_b32 v76, v76, v4, s48
    v_and_or_b32 v77, v77, v4, s49
    v_and_or_b32 v78, v78, v4, s50
    v_and_or_b32 v79, v79, v4, s51
    s_mov_b32 exec_lo, 0xff00ff
    s_mov_b32 exec_hi, 0xff00ff
    s_cmp_lg_u32 s63, 0
    s_cbranch_scc1 L_far_o
    buffer_store_dwordx4 v[76:79], v21, s[40:43], s54 offen
    s_branch L_done_o
L_far_o:
    buffer_store_dwordx4 v[76:79], v21, s[40:43], s54 offen sc1
L_done_o:
    s_mov_b64 exec, -1
    s_and_b32 s54, s45, 7
    s_lshl_b32 s54, s54, 7
    s_add_u32 s54, s54, 123904
    v_lshl_add_u32 v13, v2, 3, s54
    v_add_u32 v12, 16384, v12
    ds_read2_b64 v[52:55], v13 offset0:0 offset1:4
    ds_read2_b64 v[56:59], v13 offset0:8 offset1:12
    s_lshl_b32 s54, s3, 9
    s_lshl_b32 s55, s46, 7
    s_add_u32 s54, s54, s55
    s_add_u32 s54, s54, 131072
    s_cmp_ge_u32 s97, 1
    s_cbranch_scc1 L_fd11
    s_mov_b32 s58, 1600000
L_fw11:
    ds_read_b128 v[32:35], v9 offset:16
    s_waitcnt lgkmcnt(0)
    v_readfirstlane_b32 s97, v34
    v_readfirstlane_b32 s98, v35
    s_cmp_ge_u32 s97, 1
    s_cbranch_scc1 L_fd11
    s_sub_u32 s58, s58, 1
    s_cbranch_scc0 L_fw11
L_fd11:
    ds_read_b64_tr_b16 v[36:37], v12 offset:0
    ds_read_b64_tr_b16 v[38:39], v12 offset:2048
    ds_read_b64_tr_b16 v[44:45], v12 offset:8192
    ds_read_b64_tr_b16 v[46:47], v12 offset:10240
    ds_read_b64_tr_b16 v[40:41], v12 offset:4096
    ds_read_b64_tr_b16 v[42:43], v12 offset:6144
    ds_read_b64_tr_b16 v[48:49], v12 offset:12288
    ds_read_b64_tr_b16 v[50:51], v12 offset:14336
    v_cmp_eq_u32 vcc, 1, v3
    s_waitcnt lgkmcnt(4)
    v_mfma_f32_16x16x32_bf16 v[68:71], v[36:39], v[52:55], 0
    v_mfma_f32_16x16x32_bf16 v[72:75], v[44:47], v[52:55], 0
    s_waitcnt lgkmcnt(0)
    v_mfma_f32_16x16x32_bf16 v[68:71], v[40:43], v[56:59], v[68:71]
    v_mfma_f32_16x16x32_bf16 v[72:75], v[48:51], v[56:59], v[72:75]
    s_nop 6
    v_cndmask_b32 v76, v68, v70, vcc
    v_cndmask_b32 v77, v69, v71, vcc
    v_cndmask_b32 v78, v72, v74, vcc
    v_cndmask_b32 v79, v73, v75, vcc
    v_and_or_b32 v76, v76, v4, s48
    v_and_or_b32 v77, v77, v4, s49
    v_and_or_b32 v78, v78, v4, s50
    v_and_or_b32 v79, v79, v4, s51
    s_mov_b32 exec_lo, 0x30003
    s_mov_b32 exec_hi, 0x30003
    s_cmp_lg_u32 s63, 0
    s_cbranch_scc1 L_far_gu
    buffer_store_dwordx4 v[76:79], v28, s[40:43], s54 offen
    s_branch L_done_gu
L_far_gu:
    buffer_store_dwordx4 v[76:79], v28, s[40:43], s54 offen sc1
L_done_gu:
    s_mov_b64 exec, -1
    v_lshrrev_b32 v5, 2, v1
    v_and_b32 v6, 3, v1
    v_lshlrev_b32 v22, 11, v5
    v_lshl_add_u32 v22, v6, 4, v22
    v_lshlrev_b32 v23, 6, v5
    v_and_b32 v7, 7, v1
    v_lshlrev_b32 v24, 9, v7
    v_lshrrev_b32 v7, 3, v1
    v_lshl_add_u32 v24, v7, 4, v24
    s_lshl_b32 s54, s44, 16
    s_lshr_b32 s61, s45, 3
    s_lshl_b32 s55, s61, 9
    s_add_u32 s54, s54, s55
    s_lshl_b32 s55, s46, 7
    s_add_u32 s54, s54, s55
    s_add_u32 s54, s54, 524288
    s_add_u32 s55, s54, 32768
    s_lshl_b32 s56, s44, 11
    s_lshl_b32 s57, s61, 4
    s_add_u32 s56, s56, s57
    s_add_u32 s56, s56, 262144
    s_add_u32 s57, s56, 1024
    s_and_b32 s60, s3, 0xf8
    s_lshl_b32 s60, s60, 9
    s_lshl_b32 s61, s46, 7
    s_add_u32 s60, s60, s61
    s_add_u32 s60, s60, 131072
    s_cmp_ge_u32 s98, 1
    s_cbranch_scc1 L_fd12
    s_mov_b32 s58, 1600000
L_fw12:
    ds_read_b128 v[32:35], v9 offset:16
    s_waitcnt lgkmcnt(0)
    v_readfirstlane_b32 s98, v35
    s_nop 0
    s_cmp_ge_u32 s98, 1
    s_cbranch_scc1 L_fd12
    s_sub_u32 s58, s58, 1
    s_cbranch_scc0 L_fw12
L_fd12:
    buffer_load_dwordx4 v[52:55], v23, s[40:43], s56 offen sc1
    buffer_load_dwordx4 v[56:59], v23, s[40:43], s57 offen sc1
    buffer_load_dwordx4 v[36:39], v22, s[40:43], s54 offen sc1
    buffer_load_dwordx4 v[40:43], v22, s[40:43], s54 offen offset:64 sc1
    buffer_load_dwordx4 v[44:47], v22, s[40:43], s55 offen sc1
    buffer_load_dwordx4 v[48:51], v22, s[40:43], s55 offen offset:64 sc1
    buffer_load_dwordx4 v[60:63], v24, s[40:43], s60 offen sc1
    v_lshrrev_b32 v5, 1, v2
    v_lshlrev_b32 v25, 5, v5
    v_and_b32 v5, 3, v1
    v_lshl_add_u32 v25, v5, 3, v25
    v_and_b32 v5, 1, v2
    v_lshl_add_u32 v25, v5, 2, v25
    s_lshl_b32 s61, s46, 6
    s_add_u32 s61, s61, 127296
    v_add_u32 v25, s61, v25
    v_lshrrev_b32 v5, 3, v1
    s_lshl_b32 s61, s46, 5
    s_add_u32 s61, s61, 127552
    v_lshl_add_u32 v14, v5, 2, s61
    v_lshlrev_b32 v15, 3, v2
    v_add_u32 v15, 127296, v15
    v_lshlrev_b32 v16, 4, v2
    v_add_u32 v12, 16384, v12
    s_mov_b32 s58, 1600000
L_fw14:
    ds_read_b32 v8, v9 offset:44
    s_waitcnt lgkmcnt(0)
    v_readfirstlane_b32 s53, v8
    s_nop 0
    s_cmp_ge_u32 s53, 1
    s_cbranch_scc1 L_fd14
    s_sub_u32 s58, s58, 1
    s_cbranch_scc0 L_fw14
L_fd14:
    ds_read_b64_tr_b16 v[120:121], v12 offset:0
    ds_read_b64_tr_b16 v[122:123], v12 offset:2048
    ds_read_b64_tr_b16 v[124:125], v12 offset:4096
    ds_read_b64_tr_b16 v[126:127], v12 offset:6144
    ds_read_b64_tr_b16 v[128:129], v12 offset:8192
    ds_read_b64_tr_b16 v[130:131], v12 offset:10240
    ds_read_b64_tr_b16 v[132:133], v12 offset:12288
    ds_read_b64_tr_b16 v[134:135], v12 offset:14336
    ds_read_b64_tr_b16 v[136:137], v12 offset:16384
    ds_read_b64_tr_b16 v[138:139], v12 offset:18432
    ds_read_b64_tr_b16 v[140:141], v12 offset:20480
    ds_read_b64_tr_b16 v[142:143], v12 offset:22528
    s_mov_b32 s58, 200000
    s_waitcnt vmcnt(0)
    s_branch L_chk13
L_poll13:
    buffer_load_dwordx4 v[52:55], v23, s[40:43], s56 offen sc1
    buffer_load_dwordx4 v[56:59], v23, s[40:43], s57 offen sc1
    buffer_load_dwordx4 v[36:39], v22, s[40:43], s54 offen sc1
    buffer_load_dwordx4 v[40:43], v22, s[40:43], s54 offen offset:64 sc1
    buffer_load_dwordx4 v[44:47], v22, s[40:43], s55 offen sc1
    buffer_load_dwordx4 v[48:51], v22, s[40:43], s55 offen offset:64 sc1
    buffer_load_dwordx4 v[60:63], v24, s[40:43], s60 offen sc1
    s_waitcnt vmcnt(0)
L_chk13:
    v_xor_b32 v36, s48, v36
    v_xor_b32 v37, s49, v37
    v_xor_b32 v38, s50, v38
    v_xor_b32 v39, s51, v39
    v_xor_b32 v40, s48, v40
    v_xor_b32 v41, s49, v41
    v_xor_b32 v42, s50, v42
    v_xor_b32 v43, s51, v43
    v_xor_b32 v44, s48, v44
    v_xor_b32 v45, s49, v45
    v_xor_b32 v46, s50, v46
    v_xor_b32 v47, s51, v47
    v_xor_b32 v48, s48, v48
    v_xor_b32 v49, s49, v49
    v_xor_b32 v50, s50, v50
    v_xor_b32 v51, s51, v51
    v_xor_b32 v52, s48, v52
    v_xor_b32 v53, s49, v53
    v_xor_b32 v54, s50, v54
    v_xor_b32 v55, s51, v55
    v_xor_b32 v56, s48, v56
    v_xor_b32 v57, s49, v57
    v_xor_b32 v58, s50, v58
    v_xor_b32 v59, s51, v59
    v_xor_b32 v60, s48, v60
    v_xor_b32 v61, s49, v61
    v_xor_b32 v62, s50, v62
    v_xor_b32 v63, s51, v63
    v_or3_b32 v5, v36, v37, v38
    v_or3_b32 v6, v39, v40, v41
    v_or3_b32 v5, v5, v42, v43
    v_or3_b32 v6, v6, v44, v45
    v_or3_b32 v5, v5, v46, v47
    v_or3_b32 v6, v6, v48, v49
    v_or3_b32 v5, v5, v50, v51
    v_or3_b32 v6, v6, v52, v53
    v_or3_b32 v5, v5, v54, v55
    v_or3_b32 v6, v6, v56, v57
    v_or3_b32 v5, v5, v58, v59
    v_or3_b32 v6, v6, v60, v61
    v_or3_b32 v5, v5, v62, v63
    v_or_b32 v5, v5, v6
    v_and_b32 v5, 0xfff, v5
    v_cmp_ne_u32 vcc, 0, v5
    s_nop 0
    s_mov_b64 exec, vcc
    s_cbranch_execz L_ok13
    s_sub_u32 s58, s58, 1
    s_cbranch_scc0 L_poll13
L_ok13:
    s_mov_b64 exec, -1
    v_max_f32 v5, v52, v56
    v_add_f32_dpp v60, v60, v60 quad_perm:[1,0,3,2] row_mask:0xf bank_mask:0xf
    v_add_f32_dpp v61, v61, v61 quad_perm:[1,0,3,2] row_mask:0xf bank_mask:0xf
    v_max_f32_dpp v5, v5, v5 row_ror:4 row_mask:0xf bank_mask:0xf
    v_add_f32_dpp v62, v62, v62 quad_perm:[1,0,3,2] row_mask:0xf bank_mask:0xf
    v_add_f32_dpp v63, v63, v63 quad_perm:[1,0,3,2] row_mask:0xf bank_mask:0xf
    v_max_f32_dpp v5, v5, v5 row_ror:8 row_mask:0xf bank_mask:0xf
    v_add_f32_dpp v60, v60, v60 quad_perm:[2,3,0,1] row_mask:0xf bank_mask:0xf
    v_mov_b32 v6, v5
    v_add_f32_dpp v61, v61, v61 quad_perm:[2,3,0,1] row_mask:0xf bank_mask:0xf
    v_add_f32_dpp v62, v62, v62 quad_perm:[2,3,0,1] row_mask:0xf bank_mask:0xf
    v_permlane16_swap_b32 v5, v6
    v_add_f32_dpp v63, v63, v63 quad_perm:[2,3,0,1] row_mask:0xf bank_mask:0xf
    v_max_f32 v5, v5, v6
    v_add_f32_dpp v60, v60, v60 row_half_mirror row_mask:0xf bank_mask:0xf
    v_mov_b32 v6, v5
    v_add_f32_dpp v61, v61, v61 row_half_mirror row_mask:0xf bank_mask:0xf
    v_add_f32_dpp v62, v62, v62 row_half_mirror row_mask:0xf bank_mask:0xf
    v_permlane32_swap_b32 v5, v6
    v_add_f32_dpp v63, v63, v63 row_half_mirror row_mask:0xf bank_mask:0xf
    v_max_f32 v5, v5, v6
    v_cvt_pk_bf16_f32 v7, v60, v61
    v_sub_f32 v52, v52, v5
    v_sub_f32 v56, v56, v5
    v_cvt_pk_bf16_f32 v8, v62, v63
    v_exp_f32 v52, v52
    v_exp_f32 v56, v56
    v_lshlrev_b32 v60, 16, v7
    v_and_b32 v61, 0xffff0000, v7
    v_lshlrev_b32 v62, 16, v8
    v_and_b32 v63, 0xffff0000, v8
    v_mul_f32 v53, v52, v53
    v_mul_f32 v60, v60, v62
    v_mul_f32 v61, v61, v63
    v_fmac_f32 v53, v56, v57
    v_mul_f32 v36, v52, v36
    v_mul_f32 v37, v52, v37
    v_mul_f32 v38, v52, v38
    v_mul_f32 v39, v52, v39
    v_mul_f32 v40, v52, v40
    v_mul_f32 v41, v52, v41
    v_mul_f32 v42, v52, v42
    v_mul_f32 v43, v52, v43
    v_cvt_pk_bf16_f32 v60, v60, v61
    v_fmac_f32 v36, v56, v44
    v_fmac_f32 v37, v56, v45
    v_fmac_f32 v38, v56, v46
    v_fmac_f32 v39, v56, v47
    v_fmac_f32 v40, v56, v48
    v_fmac_f32 v41, v56, v49
    v_fmac_f32 v42, v56, v50
    v_fmac_f32 v43, v56, v51
    v_mov_b32 v6, v53
    s_mov_b32 exec_lo, 0x1010101
    s_mov_b32 exec_hi, 0x1010101
    ds_write_b32 v14, v60
    s_mov_b64 exec, -1
    s_nop 0
    v_permlane32_swap_b32 v53, v6
    v_permlane32_swap_b32 v36, v40
    v_permlane32_swap_b32 v37, v41
    v_permlane32_swap_b32 v38, v42
    v_permlane32_swap_b32 v39, v43
    v_add_f32 v53, v53, v6
    v_add_f32 v36, v36, v40
    v_add_f32 v37, v37, v41
    v_add_f32 v38, v38, v42
    v_add_f32 v39, v39, v43
    v_mov_b32 v6, v53
    v_permlane16_swap_b32 v36, v38
    v_permlane16_swap_b32 v37, v39
    v_permlane16_swap_b32 v53, v6
    v_add_f32 v36, v36, v38
    v_add_f32 v37, v37, v39
    v_add_f32 v53, v53, v6
    s_nop 1
    v_add_f32_dpp v53, v53, v53 row_ror:8 row_mask:0xf bank_mask:0xf
    v_add_f32_dpp v36, v36, v36 row_ror:8 row_mask:0xf bank_mask:0xf
    v_add_f32_dpp v37, v37, v37 row_ror:8 row_mask:0xf bank_mask:0xf
    v_add_f32_dpp v53, v53, v53 row_ror:4 row_mask:0xf bank_mask:0xf
    v_add_f32_dpp v36, v36, v36 row_ror:4 row_mask:0xf bank_mask:0xf
    v_add_f32_dpp v37, v37, v37 row_ror:4 row_mask:0xf bank_mask:0xf
    v_rcp_f32 v53, v53
    s_nop 0
    v_mul_f32 v36, v36, v53
    v_mul_f32 v37, v37, v53
    v_cvt_pk_bf16_f32 v36, v36, v37
    s_mov_b32 exec_lo, 0xf000f
    s_mov_b32 exec_hi, 0xf000f
    ds_write_b32 v25, v36
    s_mov_b64 exec, 1
    ds_add_u32 v9, v10 offset:48
    s_mov_b64 exec, -1
    s_lshl_b32 s54, s45, 3
    s_add_u32 s54, s54, s44
    s_lshl_b32 s54, s54, 8
    s_lshl_b32 s55, s46, 6
    s_add_u32 s54, s54, s55
    s_add_u32 s54, s54, 1048576
    s_mov_b32 s58, 1600000
L_fw15:
    ds_read_b32 v8, v9 offset:48
    s_waitcnt lgkmcnt(0)
    v_readfirstlane_b32 s53, v8
    s_nop 0
    s_cmp_ge_u32 s53, 4
    s_cbranch_scc1 L_fd15
    s_sub_u32 s58, s58, 1
    s_cbranch_scc0 L_fw15
L_fd15:
    ds_read2_b64 v[88:91], v15 offset0:0 offset1:4
    ds_read2_b64 v[92:95], v15 offset0:8 offset1:12
    ds_read2_b64 v[96:99], v15 offset0:16 offset1:20
    ds_read2_b64 v[100:103], v15 offset0:24 offset1:28
    ds_read2_b64 v[104:107], v15 offset0:32 offset1:36
    ds_read2_b64 v[108:111], v15 offset0:40 offset1:44
    s_waitcnt lgkmcnt(5)
    v_mfma_f32_16x16x32_bf16 v[68:71], v[120:123], v[88:91], 0
    s_waitcnt lgkmcnt(4)
    v_mfma_f32_16x16x32_bf16 v[68:71], v[124:127], v[92:95], v[68:71]
    s_waitcnt lgkmcnt(3)
    v_mfma_f32_16x16x32_bf16 v[68:71], v[128:131], v[96:99], v[68:71]
    s_waitcnt lgkmcnt(2)
    v_mfma_f32_16x16x32_bf16 v[68:71], v[132:135], v[100:103], v[68:71]
    s_waitcnt lgkmcnt(1)
    v_mfma_f32_16x16x32_bf16 v[68:71], v[136:139], v[104:107], v[68:71]
    s_waitcnt lgkmcnt(0)
    v_mfma_f32_16x16x32_bf16 v[68:71], v[140:143], v[108:111], v[68:71]
    s_nop 7
    v_and_or_b32 v76, v68, v4, s48
    v_and_or_b32 v77, v69, v4, s49
    v_and_or_b32 v78, v70, v4, s50
    v_and_or_b32 v79, v71, v4, s51
    s_mov_b32 exec_lo, 0x10001
    s_mov_b32 exec_hi, 0x10001
    buffer_store_dwordx4 v[76:79], v16, s[40:43], s54 offen sc1
    s_waitcnt vmcnt(0)
    s_mov_b64 exec, 1
    ds_add_u32 v9, v10 offset:52
    s_mov_b64 exec, -1
L_fin:
L_end:
    s_endpgm
.section .rodata,"a"
.p2align 6
.amdhsa_kernel parallel_sum__sliding_block_cached__glu_gated_bilinear__decode_kernel
  .amdhsa_next_free_vgpr 176
  .amdhsa_next_free_sgpr 102
  .amdhsa_accum_offset 176
  .amdhsa_group_segment_fixed_size 0
  .amdhsa_kernarg_size 96
  .amdhsa_user_sgpr_count 2
  .amdhsa_user_sgpr_kernarg_segment_ptr 1
  .amdhsa_system_sgpr_workgroup_id_x 1
.end_amdhsa_kernel
```
